```python
import torch

def _softmax(x, axis=-1):
    return torch.softmax(x, dim=axis)
def _gelu(x):
    return torch.nn.functional.gelu(x, approximate="tanh")
def _silu(x):
    return torch.nn.functional.silu(x)
def _sigmoid(x):
    return torch.sigmoid(x)
def _layernorm(x, axis=-1, eps=1e-5):
    m = x.mean(dim=axis, keepdim=True)
    v = x.var(dim=axis, keepdim=True, unbiased=False)
    return (x - m) / torch.sqrt(v + eps)
def _scatter_add(tgt, idx, src, axis=0):
    return tgt.clone().index_add_(axis, idx, src)
def _segment_sum(src, seg, n):
    out = torch.zeros((n,) + src.shape[1:], dtype=src.dtype)
    return out.index_add_(0, seg, src)
def _pad(x, pw):
    flat = tuple(v for pair in reversed(pw) for v in pair)
    return torch.nn.functional.pad(x, flat)

kernel_name = 'standalone__sliding_block_cached__decode'

def setup_inputs():

    _w = (lambda a: (lambda t: t.to(torch.bfloat16) if t.is_floating_point() else t)(torch.as_tensor(a)))
    B, Sq, D = 2, 1, 512
    Hq, Hkv, Sk, Dh = 32, 8, 32768, 128
    assert Hq % Hkv == 0, (Hq, Hkv)
    return {
        "x": _w((lambda *s: torch.randn(*s, dtype=torch.bfloat16) * 0.8)(B, Sq, D)),
        "k_cache": _w((lambda *s: torch.randn(*s, dtype=torch.bfloat16) * 0.8)(B, Hkv, Sk, Dh)),
        "v_cache": _w((lambda *s: torch.randn(*s, dtype=torch.bfloat16) * 0.05)(B, Hkv, Sk, Dh)),
        "wq": _w((lambda *s: torch.randn(*s, dtype=torch.bfloat16) * 0.8)(D, Hq * Dh) * (D ** -0.5)),
        "wo": _w((lambda *s: torch.randn(*s, dtype=torch.bfloat16) * 0.05)(Hq * Dh, D) * ((Hq * Dh) ** -0.5)),
    }

def reference(x, k_cache, v_cache, wq, wo):
    B, Sq, D = x.shape
    Hq, Dh = 32, 128
    Hkv, Sk = k_cache.shape[1], k_cache.shape[2]
    W = min(4096, max(256, Sk // 4))
    rep = Hq // Hkv
    q = (lambda x, *d: x.permute(*d))((x @ wq).reshape(B, Sq, Hq, Dh), 0, 2, 1, 3)
    k = (lambda x, n, axis: torch.repeat_interleave(x, n, dim=axis))(k_cache[:, :, Sk - W:, :], rep, axis=1)
    v = (lambda x, n, axis: torch.repeat_interleave(x, n, dim=axis))(v_cache[:, :, Sk - W:, :], rep, axis=1)
    scores = torch.einsum("bhqd,bhkd->bhqk", q, k) * (Dh ** -0.5)
    p = _softmax(scores, axis=-1)
    o = torch.einsum("bhqk,bhkd->bhqd", p, v)
    return (lambda x, *d: x.permute(*d))(o, 0, 2, 1, 3).reshape(B, Sq, Hq * Dh) @ wo
```

```asm
; @launch grid=(256,1,1) block=(384,1,1) lds=153344
.amdgcn_target "amdgcn-amd-amdhsa--gfx950"
.text
.globl standalone__sliding_block_cached__decode_kernel
.p2align 8
.type standalone__sliding_block_cached__decode_kernel,@function
standalone__sliding_block_cached__decode_kernel:
L_start:
    s_cmp_ge_u32 s2, 256
    s_cbranch_scc1 L_end
    s_load_dwordx16 s[4:19], s[0:1], 0
    v_lshrrev_b32 v1, 6, v0
    v_and_b32 v0, 63, v0
    s_and_b32 s21, s2, 7
    v_readfirstlane_b32 s20, v1
    s_lshr_b32 s22, s2, 3
    s_lshr_b32 s23, s22, 4
    s_and_b32 s24, s22, 15
    v_and_b32 v1, 15, v0
    v_lshrrev_b32 v2, 4, v0
    s_cmp_eq_u32 s20, 1
    s_cbranch_scc1 L_loader
    s_cmp_eq_u32 s20, 0
    s_cbranch_scc1 L_qstart
    s_getpc_b64 s[36:37]
L_pc:
    s_and_b32 s3, s22, 3
    s_lshl_b32 s3, s3, 2
    s_add_u32 s3, s3, s20
    s_lshl_b32 s3, s3, 10
    s_sub_u32 s3, s3, 2048
    v_lshl_add_u32 v20, v0, 4, s3
    v_min_u32 v20, L_end - L_pc - 16, v20
    global_load_dword v32, v20, s[36:37]
    s_barrier
    s_branch L_compute
L_qstart:
    v_lshlrev_b32 v3, 2, v0
    v_add_u32 v3, 151552, v3
    v_cmp_gt_u32 vcc, 16, v0
    s_lshr_b32 s25, s22, 3
    s_and_b32 s26, s22, 7
    v_cndmask_b32_e64 v4, 0, -1, vcc
    ds_write_b32 v3, v4
    v_and_b32 v3, 1, v0
    v_lshlrev_b32 v3, 10, v3
    v_lshl_add_u32 v3, v2, 4, v3
    s_lshl_b32 s27, s25, 8
    v_add_u32 v3, s27, v3
    v_and_b32 v4, 7, v0
    v_and_b32 v5, 1, v2
    v_lshlrev_b32 v5, 1, v5
    v_xor_b32 v4, v4, v5
    v_lshlrev_b32 v4, 4, v4
    v_lshrrev_b32 v5, 3, v0
    v_lshl_add_u32 v4, v5, 13, v4
    v_xor_b32 v5, 64, v4
    v_add_u32 v5, 64512, v5
    s_lshl_b32 s27, s25, 20
    s_lshl_b32 s3, s21, 10
    s_add_u32 s27, s27, s3
    s_lshl_b32 s3, s26, 7
    s_add_u32 s27, s27, s3
    s_sub_u32 s30, 4194304, s27
    s_mov_b32 s31, 0x20000
    s_mov_b32 m0, 131072
    s_mov_b32 s3, 0
    s_waitcnt lgkmcnt(0)
    s_add_u32 s28, s10, s27
    s_addc_u32 s29, s11, 0
    global_load_dwordx4 v[8:11], v3, s[4:5] offset:0
    global_load_dwordx4 v[12:15], v3, s[4:5] offset:64
    global_load_dwordx4 v[16:19], v3, s[4:5] offset:128
    global_load_dwordx4 v[20:23], v3, s[4:5] offset:192
L_wql:
    buffer_load_dwordx4 v4, s[28:31], s3 offen nt lds
    buffer_load_dwordx4 v5, s[28:31], s3 offen offset:1024 nt lds
    s_add_u32 m0, m0, 2048
    s_add_u32 s3, s3, 0x20000
    s_cmp_lt_u32 s3, 0x100000
    s_cbranch_scc1 L_wql
    s_barrier
    s_branch L_qrest
L_loader:
    v_xor_b32 v3, v1, v2
    v_lshlrev_b32 v3, 4, v3
    v_lshl_add_u32 v4, v2, 8, v3
    v_xor_b32 v5, 64, v4
    v_xor_b32 v6, 128, v4
    v_xor_b32 v7, 192, v4
    v_mov_b32 v11, 151616
    s_lshl_b32 s25, s23, 3
    s_add_u32 s25, s25, s21
    s_lshl_b32 s25, s25, 23
    s_lshl_b32 s26, s24, 16
    s_add_u32 s25, s25, s26
    s_add_u32 s25, s25, 7340032
    s_lshl_b32 s45, s24, 12
    s_mov_b32 s48, 0
    s_mov_b32 s30, 65536
    s_mov_b32 s31, 0x20000
    s_mov_b32 m0, 0
    s_waitcnt lgkmcnt(0)
    s_add_u32 s28, s6, s25
    s_addc_u32 s29, s7, 0
    s_barrier
L_l1:
    s_waitcnt vmcnt(20)
    s_add_i32 s46, m0, -20480
    s_max_i32 s48, s48, s46
    v_mov_b32 v12, s48
    ds_write_b32 v11, v12 offset:4
    buffer_load_dwordx4 v4, s[28:31], s45 offen offset:0 nt lds
    buffer_load_dwordx4 v5, s[28:31], s45 offen offset:1024 nt lds
    buffer_load_dwordx4 v6, s[28:31], s45 offen offset:2048 nt lds
    buffer_load_dwordx4 v7, s[28:31], s45 offen offset:3072 nt lds
    s_add_u32 s45, s45, 4096
    s_and_b32 s45, s45, 65535
    s_add_u32 m0, m0, 4096
    s_cmp_lt_u32 m0, 65536
    s_cbranch_scc1 L_l1
    v_lshlrev_b32 v3, 1, v2
    v_xor_b32 v3, v1, v3
    v_lshlrev_b32 v3, 4, v3
    v_lshl_add_u32 v8, v2, 8, v3
    v_xor_b32 v9, 0x80, v8
    s_add_u32 s32, s8, s25
    s_addc_u32 s33, s9, 0
    s_mov_b32 s34, 65536
    s_mov_b32 s35, 0x20000
    s_load_dwordx2 s[50:51], s[18:19], 0
    s_mov_b32 s49, 106496
    s_and_b32 s3, s22, 3
    s_cmp_eq_u32 s3, 1
    s_cselect_b32 s49, 106496, s49
    s_and_b32 s3, s22, 7
    s_cmp_eq_u32 s3, 3
    s_cselect_b32 s49, 106496, s49
L_lv0:
    s_waitcnt vmcnt(20)
    s_add_i32 s46, m0, -20480
    s_max_i32 s48, s48, s46
    v_mov_b32 v12, s48
    ds_write_b32 v11, v12 offset:4
    buffer_load_dwordx4 v8, s[32:35], s45 offen offset:0 nt lds
    buffer_load_dwordx4 v8, s[32:35], s45 offen offset:1024 nt lds
    buffer_load_dwordx4 v9, s[32:35], s45 offen offset:2048 nt lds
    buffer_load_dwordx4 v9, s[32:35], s45 offen offset:3072 nt lds
    s_add_u32 s45, s45, 4096
    s_and_b32 s45, s45, 65535
    s_add_u32 m0, m0, 4096
    s_cmp_lt_u32 m0, s49
    s_cbranch_scc1 L_lv0
    s_mov_b32 s40, s18
    s_mov_b32 s41, s19
    s_mov_b32 s42, 3276800
    s_mov_b32 s43, 0x20000
    s_lshl_b32 s44, s21, 5
    s_add_u32 s44, s44, s22
    v_lshl_add_u32 v10, v2, 10, v3
    v_xor_b32 v15, 0x80, v10
    s_lshl_b32 s26, s21, 19
    s_lshr_b32 s27, s22, 2
    s_lshl_b32 s27, s27, 16
    s_add_u32 s26, s26, s27
    s_and_b32 s27, s22, 3
    s_lshl_b32 s27, s27, 8
    s_add_u32 s26, s26, s27
    s_add_u32 s36, s12, s26
    s_addc_u32 s37, s13, 0
    s_sub_u32 s38, 4194304, s26
    s_mov_b32 s39, 0x20000
L_lv1:
    s_waitcnt vmcnt(40)
    s_add_i32 s46, m0, -40960
    s_max_i32 s48, s48, s46
    v_mov_b32 v12, s48
    ds_write_b32 v11, v12 offset:4
    buffer_load_dwordx4 v8, s[32:35], s45 offen offset:0 nt lds
    buffer_load_dwordx4 v8, s[32:35], s45 offen offset:1024 nt lds
    buffer_load_dwordx4 v9, s[32:35], s45 offen offset:2048 nt lds
    buffer_load_dwordx4 v9, s[32:35], s45 offen offset:3072 nt lds
    s_add_u32 s45, s45, 4096
    s_and_b32 s45, s45, 65535
    s_add_u32 m0, m0, 4096
    s_cmp_lt_u32 m0, 131072
    s_cbranch_scc1 L_lv1
    s_mov_b32 s47, 0x1000000
L_wqc:
    ds_read_b32 v13, v11 offset:12
    s_sub_u32 s47, s47, 1
    s_cbranch_scc1 L_wqc_done
    s_waitcnt lgkmcnt(0)
    v_cmp_gt_i32 vcc, 1, v13
    s_cbranch_vccz L_wqc_done
    s_branch L_wqc
L_wqc_done:
    s_waitcnt lgkmcnt(0)
    s_add_u32 s50, s50, 0x9e3779b9
    s_addc_u32 s51, s51, 0x7f4a7c15
    s_and_b32 s52, s51, 0xff
    s_movk_i32 s53, 0xff
    s_waitcnt vmcnt(40)
    s_max_i32 s48, s48, 90112
    v_mov_b32 v12, s48
    ds_write_b32 v11, v12 offset:4
    s_mov_b32 m0, 131072
    s_mov_b32 s3, 0
    buffer_load_dwordx4 v10, s[36:39], s3 offen nt lds
    s_mov_b32 m0, 132096
    s_mov_b32 s3, 4096
    buffer_load_dwordx4 v10, s[36:39], s3 offen nt lds
    s_mov_b32 m0, 133120
    s_mov_b32 s3, 8192
    buffer_load_dwordx4 v15, s[36:39], s3 offen nt lds
    s_mov_b32 m0, 134144
    s_mov_b32 s3, 12288
    buffer_load_dwordx4 v15, s[36:39], s3 offen nt lds
    s_waitcnt vmcnt(40)
    s_max_i32 s48, s48, 94208
    v_mov_b32 v12, s48
    ds_write_b32 v11, v12 offset:4
    s_mov_b32 m0, 135168
    s_mov_b32 s3, 16384
    buffer_load_dwordx4 v10, s[36:39], s3 offen nt lds
    s_mov_b32 m0, 136192
    s_mov_b32 s3, 20480
    buffer_load_dwordx4 v10, s[36:39], s3 offen nt lds
    s_mov_b32 m0, 137216
    s_mov_b32 s3, 24576
    buffer_load_dwordx4 v15, s[36:39], s3 offen nt lds
    s_mov_b32 m0, 138240
    s_mov_b32 s3, 28672
    buffer_load_dwordx4 v15, s[36:39], s3 offen nt lds
    s_waitcnt vmcnt(40)
    s_max_i32 s48, s48, 98304
    v_mov_b32 v12, s48
    ds_write_b32 v11, v12 offset:4
    s_mov_b32 m0, 139264
    s_mov_b32 s3, 32768
    buffer_load_dwordx4 v10, s[36:39], s3 offen nt lds
    s_mov_b32 m0, 140288
    s_mov_b32 s3, 36864
    buffer_load_dwordx4 v10, s[36:39], s3 offen nt lds
    s_mov_b32 m0, 141312
    s_mov_b32 s3, 40960
    buffer_load_dwordx4 v15, s[36:39], s3 offen nt lds
    s_mov_b32 m0, 142336
    s_mov_b32 s3, 45056
    buffer_load_dwordx4 v15, s[36:39], s3 offen nt lds
    s_waitcnt vmcnt(40)
    s_max_i32 s48, s48, 102400
    v_mov_b32 v12, s48
    ds_write_b32 v11, v12 offset:4
    s_mov_b32 m0, 143360
    s_mov_b32 s3, 49152
    buffer_load_dwordx4 v10, s[36:39], s3 offen nt lds
    s_mov_b32 m0, 144384
    s_mov_b32 s3, 53248
    buffer_load_dwordx4 v10, s[36:39], s3 offen nt lds
    s_mov_b32 m0, 145408
    s_mov_b32 s3, 57344
    buffer_load_dwordx4 v15, s[36:39], s3 offen nt lds
    s_mov_b32 m0, 146432
    s_mov_b32 s3, 61440
    buffer_load_dwordx4 v15, s[36:39], s3 offen nt lds
    v_mov_b32 v12, 106496
    s_waitcnt vmcnt(40)
    ds_write_b32 v11, v12 offset:4
    v_mov_b32 v12, 114688
    s_waitcnt vmcnt(32)
    ds_write_b32 v11, v12 offset:4
    v_mov_b32 v12, 122880
    s_waitcnt vmcnt(24)
    ds_write_b32 v11, v12 offset:4
    v_mov_b32 v12, 131072
    s_waitcnt vmcnt(16)
    ds_write_b32 v11, v12 offset:4
    v_mov_b32 v12, 147456
    s_waitcnt vmcnt(0)
    ds_write_b32 v11, v12 offset:4
    v_lshrrev_b32 v14, 1, v0
    v_mul_u32_u24 v14, 2176, v14
    v_and_b32 v13, 1, v0
    v_lshl_add_u32 v14, v13, 4, v14
    s_lshr_b32 s26, s21, 1
    s_mul_i32 s3, s26, 139264
    s_and_b32 s27, s44, 63
    s_lshl_b32 s27, s27, 5
    s_add_u32 s3, s3, s27
    s_add_u32 s3, s3, 2686976
    s_add_u32 s46, s3, 69632
    s_and_b32 s49, s21, 1
    s_lshl_b32 s49, s49, 10
    s_lshl_b32 s26, s26, 8
    s_add_u32 s49, s49, s26
    s_lshl_b32 s26, s22, 3
    s_add_u32 s49, s49, s26
    v_lshlrev_b32 v3, 2, v13
    v_lshrrev_b32 v4, 5, v0
    v_lshl_add_u32 v3, v4, 1, v3
    v_add_u32 v3, s49, v3
    s_lshl_b32 s27, s22, 7
    s_add_u32 s27, s27, 32768
    s_add_u32 s58, s18, s27
    s_addc_u32 s59, s19, 0
    s_mov_b32 s47, 0x200000
    s_branch L_gate1
L_gate:
L_gate1:
    s_load_dwordx16 s[84:99], s[58:59], 0 glc
    s_sub_u32 s47, s47, 1
    s_cbranch_scc1 L_gate_done
    s_waitcnt lgkmcnt(0)
    s_cmp_lg_u64 s[84:85], s[50:51]
    s_cbranch_scc1 L_gate
    s_cmp_lg_u64 s[86:87], s[50:51]
    s_cbranch_scc1 L_gate
    s_cmp_lg_u64 s[88:89], s[50:51]
    s_cbranch_scc1 L_gate
    s_cmp_lg_u64 s[90:91], s[50:51]
    s_cbranch_scc1 L_gate
    s_cmp_lg_u64 s[92:93], s[50:51]
    s_cbranch_scc1 L_gate
    s_cmp_lg_u64 s[94:95], s[50:51]
    s_cbranch_scc1 L_gate
    s_cmp_lg_u64 s[96:97], s[50:51]
    s_cbranch_scc1 L_gate
    s_cmp_lg_u64 s[98:99], s[50:51]
    s_cbranch_scc1 L_gate
L_gate_done:
L_fpoll:
    buffer_load_dwordx4 v[16:19], v14, s[40:43], s3 offen sc1
    buffer_load_dwordx4 v[20:23], v14, s[40:43], s46 offen sc1
    s_sub_u32 s47, s47, 1
    s_cbranch_scc1 L_fpoll_done
    s_waitcnt vmcnt(1)
    v_xor_b32 v16, s52, v16
    v_xor_b32 v18, s52, v18
    v_bitop3_b32 v13, v17, v19, s50 bitop3:0x7e
    v_or_b32 v12, v16, v18
    s_waitcnt vmcnt(0)
    v_xor_b32 v20, s52, v20
    v_xor_b32 v22, s52, v22
    v_bitop3_b32 v13, v13, v21, s50 bitop3:0xf6
    v_or3_b32 v12, v12, v20, v22
    v_bitop3_b32 v13, v13, v23, s50 bitop3:0xf6
    v_and_or_b32 v12, v12, s53, v13
    v_cmp_ne_u32 vcc, 0, v12
    s_mov_b64 exec, vcc
    s_cbranch_vccnz L_fpoll
L_fpoll_done:
    s_mov_b64 exec, -1
    v_add_f32 v16, v16, v20
    v_add_f32 v18, v18, v22
    s_nop 1
    v_permlane32_swap_b32 v16, v18
    v_add_f32 v16, v16, v18
    v_mov_b32 v18, v16
    s_nop 1
    v_permlane16_swap_b32 v16, v18
    v_add_f32 v16, v16, v18
    s_nop 1
    v_add_f32_dpp v16, v16, v16 quad_perm:[2,3,0,1] row_mask:0xf bank_mask:0xf
    s_nop 1
    v_add_f32_dpp v16, v16, v16 row_ror:4 row_mask:0xf bank_mask:0xf
    s_nop 1
    v_add_f32_dpp v16, v16, v16 row_ror:8 row_mask:0xf bank_mask:0xf
    s_mov_b32 exec_lo, 3
    v_cvt_pk_bf16_f32 v16, v16, v16
    s_mov_b32 exec_hi, 3
    global_store_short v3, v16, s[14:15]
    s_cmp_lg_u32 s2, 0
    s_cbranch_scc1 L_noep
    s_mov_b64 exec, 1
    v_mov_b32 v4, s50
    v_mov_b32 v5, s51
    v_mov_b32 v3, 0
    global_store_dwordx2 v3, v[4:5], s[18:19]
L_noep:
    s_endpgm
L_qrest:
    s_setprio 3
    s_load_dwordx2 s[50:51], s[18:19], 0
    s_mov_b32 s40, s18
    s_mov_b32 s41, s19
    s_mov_b32 s42, 3276800
    s_mov_b32 s43, 0x20000
    s_lshl_b32 s44, s21, 5
    s_add_u32 s44, s44, s22
    s_lshl_b32 s48, s21, 15
    s_lshl_b32 s3, s25, 12
    s_add_u32 s48, s48, s3
    s_lshl_b32 s3, s26, 9
    s_add_u32 s48, s48, s3
    s_lshl_b32 s49, s44, 3
    s_add_u32 s49, s49, 262144
    v_lshlrev_b32 v90, 3, v0
    s_getreg_b32 s54, hwreg(HW_REG_XCC_ID)
    s_and_b32 s54, s54, 15
    s_lshl_b32 s54, s54, 8
    v_lshrrev_b32 v6, 2, v1
    v_lshl_add_u32 v6, v2, 3, v6
    v_lshlrev_b32 v6, 7, v6
    v_and_b32 v7, 3, v0
    v_lshl_add_u32 v6, v7, 3, v6
    v_lshrrev_b32 v7, 3, v1
    v_and_b32 v28, 1, v2
    v_lshl_or_b32 v7, v28, 1, v7
    v_lshl_add_u32 v6, v7, 5, v6
    v_add_u32 v28, 131072, v6
    v_xor_b32 v29, 32, v28
    v_xor_b32 v30, 64, v28
    v_xor_b32 v31, 96, v28
    s_waitcnt lgkmcnt(0)
    s_add_u32 s50, s50, 0x9e3779b9
    s_addc_u32 s51, s51, 0x7f4a7c15
    s_and_b32 s52, s51, 0xff
    s_movk_i32 s53, 0xff
    s_or_b32 s55, s54, s52
    s_waitcnt vmcnt(12) lgkmcnt(7)
    ds_read_b64_tr_b16 v[32:33], v28 offset:0
    ds_read_b64_tr_b16 v[34:35], v28 offset:512
    ds_read_b64_tr_b16 v[36:37], v29 offset:0
    ds_read_b64_tr_b16 v[38:39], v29 offset:512
    ds_read_b64_tr_b16 v[40:41], v30 offset:0
    ds_read_b64_tr_b16 v[42:43], v30 offset:512
    ds_read_b64_tr_b16 v[44:45], v31 offset:0
    ds_read_b64_tr_b16 v[46:47], v31 offset:512
    s_waitcnt vmcnt(8) lgkmcnt(7)
    ds_read_b64_tr_b16 v[48:49], v28 offset:4096
    ds_read_b64_tr_b16 v[50:51], v28 offset:4608
    ds_read_b64_tr_b16 v[52:53], v29 offset:4096
    ds_read_b64_tr_b16 v[54:55], v29 offset:4608
    ds_read_b64_tr_b16 v[56:57], v30 offset:4096
    ds_read_b64_tr_b16 v[58:59], v30 offset:4608
    ds_read_b64_tr_b16 v[60:61], v31 offset:4096
    ds_read_b64_tr_b16 v[62:63], v31 offset:4608
    s_waitcnt lgkmcnt(8)
    v_mfma_f32_16x16x32_bf16 v[64:67], v[8:11], v[32:35], 0
    v_mfma_f32_16x16x32_bf16 v[68:71], v[8:11], v[36:39], 0
    v_mfma_f32_16x16x32_bf16 v[72:75], v[8:11], v[40:43], 0
    v_mfma_f32_16x16x32_bf16 v[76:79], v[8:11], v[44:47], 0
    s_waitcnt vmcnt(4) lgkmcnt(7)
    ds_read_b64_tr_b16 v[32:33], v28 offset:8192
    ds_read_b64_tr_b16 v[34:35], v28 offset:8704
    ds_read_b64_tr_b16 v[36:37], v29 offset:8192
    ds_read_b64_tr_b16 v[38:39], v29 offset:8704
    ds_read_b64_tr_b16 v[40:41], v30 offset:8192
    ds_read_b64_tr_b16 v[42:43], v30 offset:8704
    ds_read_b64_tr_b16 v[44:45], v31 offset:8192
    ds_read_b64_tr_b16 v[46:47], v31 offset:8704
    s_waitcnt lgkmcnt(8)
    v_mfma_f32_16x16x32_bf16 v[64:67], v[12:15], v[48:51], v[64:67]
    v_mfma_f32_16x16x32_bf16 v[68:71], v[12:15], v[52:55], v[68:71]
    v_mfma_f32_16x16x32_bf16 v[72:75], v[12:15], v[56:59], v[72:75]
    v_mfma_f32_16x16x32_bf16 v[76:79], v[12:15], v[60:63], v[76:79]
    s_waitcnt vmcnt(0) lgkmcnt(7)
    ds_read_b64_tr_b16 v[48:49], v28 offset:12288
    ds_read_b64_tr_b16 v[50:51], v28 offset:12800
    ds_read_b64_tr_b16 v[52:53], v29 offset:12288
    ds_read_b64_tr_b16 v[54:55], v29 offset:12800
    ds_read_b64_tr_b16 v[56:57], v30 offset:12288
    ds_read_b64_tr_b16 v[58:59], v30 offset:12800
    ds_read_b64_tr_b16 v[60:61], v31 offset:12288
    ds_read_b64_tr_b16 v[62:63], v31 offset:12800
    s_waitcnt lgkmcnt(8)
    v_mfma_f32_16x16x32_bf16 v[64:67], v[16:19], v[32:35], v[64:67]
    v_mfma_f32_16x16x32_bf16 v[68:71], v[16:19], v[36:39], v[68:71]
    v_mfma_f32_16x16x32_bf16 v[72:75], v[16:19], v[40:43], v[72:75]
    v_mfma_f32_16x16x32_bf16 v[76:79], v[16:19], v[44:47], v[76:79]
    s_waitcnt lgkmcnt(0)
    v_mfma_f32_16x16x32_bf16 v[64:67], v[20:23], v[48:51], v[64:67]
    v_mfma_f32_16x16x32_bf16 v[68:71], v[20:23], v[52:55], v[68:71]
    v_mfma_f32_16x16x32_bf16 v[72:75], v[20:23], v[56:59], v[72:75]
    v_mfma_f32_16x16x32_bf16 v[76:79], v[20:23], v[60:63], v[76:79]
    v_mov_b32 v6, 151616
    v_mov_b32 v7, 1
    ds_write_b32 v6, v7 offset:12
    v_mov_b32 v81, s50
    v_mov_b32 v83, s50
    v_mov_b32 v85, s50
    v_mov_b32 v84, s55
    v_mov_b32 v86, s52
    v_mov_b32_dpp v64, v68 quad_perm:[0,1,2,3] row_mask:0x2 bank_mask:0xf
    v_mov_b32_dpp v65, v69 quad_perm:[0,1,2,3] row_mask:0x2 bank_mask:0xf
    v_mov_b32_dpp v64, v72 quad_perm:[0,1,2,3] row_mask:0x4 bank_mask:0xf
    v_mov_b32_dpp v65, v73 quad_perm:[0,1,2,3] row_mask:0x4 bank_mask:0xf
    v_mov_b32_dpp v64, v76 quad_perm:[0,1,2,3] row_mask:0x8 bank_mask:0xf
    v_mov_b32_dpp v65, v77 quad_perm:[0,1,2,3] row_mask:0x8 bank_mask:0xf
    v_add_u32 v64, 0x80, v64
    v_bfi_b32 v80, s53, v86, v64
    v_add_u32 v65, 0x80, v65
    v_bfi_b32 v82, s53, v86, v65
    s_add_u32 s34, s48, 524288
    s_add_u32 s35, s48, 540672
    s_add_u32 s36, s49, 524288
    buffer_store_dwordx2 v[80:81], v90, s[40:43], s34 offen
    buffer_store_dwordx2 v[82:83], v90, s[40:43], s35 offen
    s_mov_b64 exec, 1
    buffer_store_dwordx2 v[84:85], v90, s[40:43], s36 offen
    s_mov_b64 exec, -1
    s_lshl_b32 s3, s21, 15
    s_lshl_b32 s45, s23, 14
    s_add_u32 s3, s3, s45
    s_add_u32 s3, s3, 524288
    s_lshl_b32 s46, s21, 8
    s_add_u32 s46, s46, 786432
    v_lshlrev_b32 v4, 4, v0
    v_lshlrev_b32 v5, 2, v0
    v_add_u32 v5, 147456, v5
    v_and_b32 v3, 31, v0
    v_lshlrev_b32 v3, 3, v3
    s_mov_b32 s47, 0x1000000
L_tw:
    ds_read_b32 v8, v6 offset:4
    s_sub_u32 s47, s47, 1
    s_cbranch_scc1 L_tw_done
    s_waitcnt lgkmcnt(0)
    v_cmp_gt_i32 vcc, 36864, v8
    s_cbranch_vccz L_tw_done
    s_sleep 1
    s_branch L_tw
L_tw_done:
    s_mov_b32 s47, 0
L_qpoll:
    s_add_u32 s45, s3, 0
    buffer_load_dwordx4 v[8:11], v4, s[40:43], s45 offen offset:0 sc1
    buffer_load_dwordx4 v[12:15], v4, s[40:43], s45 offen offset:1024 sc1
    buffer_load_dwordx4 v[16:19], v4, s[40:43], s45 offen offset:2048 sc1
    buffer_load_dwordx4 v[20:23], v4, s[40:43], s45 offen offset:3072 sc1
    s_add_u32 s45, s3, 4096
    buffer_load_dwordx4 v[24:27], v4, s[40:43], s45 offen offset:0 sc1
    buffer_load_dwordx4 v[28:31], v4, s[40:43], s45 offen offset:1024 sc1
    buffer_load_dwordx4 v[32:35], v4, s[40:43], s45 offen offset:2048 sc1
    buffer_load_dwordx4 v[36:39], v4, s[40:43], s45 offen offset:3072 sc1
    s_add_u32 s45, s3, 8192
    buffer_load_dwordx4 v[40:43], v4, s[40:43], s45 offen offset:0 sc1
    buffer_load_dwordx4 v[44:47], v4, s[40:43], s45 offen offset:1024 sc1
    buffer_load_dwordx4 v[48:51], v4, s[40:43], s45 offen offset:2048 sc1
    buffer_load_dwordx4 v[52:55], v4, s[40:43], s45 offen offset:3072 sc1
    s_add_u32 s45, s3, 12288
    buffer_load_dwordx4 v[56:59], v4, s[40:43], s45 offen offset:0 sc1
    buffer_load_dwordx4 v[60:63], v4, s[40:43], s45 offen offset:1024 sc1
    buffer_load_dwordx4 v[64:67], v4, s[40:43], s45 offen offset:2048 sc1
    buffer_load_dwordx4 v[68:71], v4, s[40:43], s45 offen offset:3072 sc1
    buffer_load_dwordx2 v[72:73], v3, s[40:43], s46 offen sc1
    s_add_u32 s47, s47, 1
    s_waitcnt vmcnt(16)
    v_xor_b32 v8, s52, v8
    v_xor_b32 v10, s52, v10
    v_bitop3_b32 v89, v9, v11, s50 bitop3:0x7e
    v_or_b32 v88, v8, v10
    s_waitcnt vmcnt(15)
    v_xor_b32 v12, s52, v12
    v_xor_b32 v14, s52, v14
    v_bitop3_b32 v89, v89, v13, s50 bitop3:0xf6
    v_or3_b32 v88, v88, v12, v14
    v_bitop3_b32 v89, v89, v15, s50 bitop3:0xf6
    s_waitcnt vmcnt(14)
    v_xor_b32 v16, s52, v16
    v_xor_b32 v18, s52, v18
    v_bitop3_b32 v89, v89, v17, s50 bitop3:0xf6
    v_or3_b32 v88, v88, v16, v18
    v_bitop3_b32 v89, v89, v19, s50 bitop3:0xf6
    s_waitcnt vmcnt(13)
    v_xor_b32 v20, s52, v20
    v_xor_b32 v22, s52, v22
    v_bitop3_b32 v89, v89, v21, s50 bitop3:0xf6
    v_or3_b32 v88, v88, v20, v22
    v_bitop3_b32 v89, v89, v23, s50 bitop3:0xf6
    s_waitcnt vmcnt(12)
    v_xor_b32 v24, s52, v24
    v_xor_b32 v26, s52, v26
    v_bitop3_b32 v89, v89, v25, s50 bitop3:0xf6
    v_or3_b32 v88, v88, v24, v26
    v_bitop3_b32 v89, v89, v27, s50 bitop3:0xf6
    s_waitcnt vmcnt(11)
    v_xor_b32 v28, s52, v28
    v_xor_b32 v30, s52, v30
    v_bitop3_b32 v89, v89, v29, s50 bitop3:0xf6
    v_or3_b32 v88, v88, v28, v30
    v_bitop3_b32 v89, v89, v31, s50 bitop3:0xf6
    s_waitcnt vmcnt(10)
    v_xor_b32 v32, s52, v32
    v_xor_b32 v34, s52, v34
    v_bitop3_b32 v89, v89, v33, s50 bitop3:0xf6
    v_or3_b32 v88, v88, v32, v34
    v_bitop3_b32 v89, v89, v35, s50 bitop3:0xf6
    s_waitcnt vmcnt(9)
    v_xor_b32 v36, s52, v36
    v_xor_b32 v38, s52, v38
    v_bitop3_b32 v89, v89, v37, s50 bitop3:0xf6
    v_or3_b32 v88, v88, v36, v38
    v_bitop3_b32 v89, v89, v39, s50 bitop3:0xf6
    s_waitcnt vmcnt(8)
    v_xor_b32 v40, s52, v40
    v_xor_b32 v42, s52, v42
    v_bitop3_b32 v89, v89, v41, s50 bitop3:0xf6
    v_or3_b32 v88, v88, v40, v42
    v_bitop3_b32 v89, v89, v43, s50 bitop3:0xf6
    s_waitcnt vmcnt(7)
    v_xor_b32 v44, s52, v44
    v_xor_b32 v46, s52, v46
    v_bitop3_b32 v89, v89, v45, s50 bitop3:0xf6
    v_or3_b32 v88, v88, v44, v46
    v_bitop3_b32 v89, v89, v47, s50 bitop3:0xf6
    s_waitcnt vmcnt(6)
    v_xor_b32 v48, s52, v48
    v_xor_b32 v50, s52, v50
    v_bitop3_b32 v89, v89, v49, s50 bitop3:0xf6
    v_or3_b32 v88, v88, v48, v50
    v_bitop3_b32 v89, v89, v51, s50 bitop3:0xf6
    s_waitcnt vmcnt(5)
    v_xor_b32 v52, s52, v52
    v_xor_b32 v54, s52, v54
    v_bitop3_b32 v89, v89, v53, s50 bitop3:0xf6
    v_or3_b32 v88, v88, v52, v54
    v_bitop3_b32 v89, v89, v55, s50 bitop3:0xf6
    s_waitcnt vmcnt(4)
    v_xor_b32 v56, s52, v56
    v_xor_b32 v58, s52, v58
    v_bitop3_b32 v89, v89, v57, s50 bitop3:0xf6
    v_or3_b32 v88, v88, v56, v58
    v_bitop3_b32 v89, v89, v59, s50 bitop3:0xf6
    s_waitcnt vmcnt(3)
    v_xor_b32 v60, s52, v60
    v_xor_b32 v62, s52, v62
    v_bitop3_b32 v89, v89, v61, s50 bitop3:0xf6
    v_or3_b32 v88, v88, v60, v62
    v_bitop3_b32 v89, v89, v63, s50 bitop3:0xf6
    s_waitcnt vmcnt(2)
    v_xor_b32 v64, s52, v64
    v_xor_b32 v66, s52, v66
    v_bitop3_b32 v89, v89, v65, s50 bitop3:0xf6
    v_or3_b32 v88, v88, v64, v66
    v_bitop3_b32 v89, v89, v67, s50 bitop3:0xf6
    s_waitcnt vmcnt(1)
    v_xor_b32 v68, s52, v68
    v_xor_b32 v70, s52, v70
    v_bitop3_b32 v89, v89, v69, s50 bitop3:0xf6
    v_or3_b32 v88, v88, v68, v70
    v_bitop3_b32 v89, v89, v71, s50 bitop3:0xf6
    s_waitcnt vmcnt(0)
    v_xor_b32 v72, s52, v72
    v_or_b32 v88, v88, v72
    v_bitop3_b32 v89, v89, v73, s50 bitop3:0xf6
    v_and_or_b32 v88, v88, s53, v89
    v_cmp_ne_u32 vcc, 0, v88
    s_cbranch_vccz L_qok
    s_cmp_lt_u32 s47, 4
    s_cbranch_scc1 L_qpoll
    s_cmp_lg_u32 s47, 4
    s_cbranch_scc1 L_qnob
    s_add_u32 s34, s48, 1048576
    s_add_u32 s35, s48, 1064960
    s_add_u32 s36, s49, 1048576
    buffer_store_dwordx2 v[80:81], v90, s[40:43], s34 offen sc1
    buffer_store_dwordx2 v[82:83], v90, s[40:43], s35 offen sc1
    s_mov_b64 exec, 1
    buffer_store_dwordx2 v[84:85], v90, s[40:43], s36 offen sc1
    s_mov_b64 exec, -1
L_qnob:
    s_xor_b32 s3, s3, 1572864
    s_xor_b32 s46, s46, 1572864
    s_cmp_lt_u32 s47, 0x100000
    s_cbranch_scc1 L_qpoll
L_qok:
    v_add_f32 v8, v8, v24
    v_add_f32 v40, v40, v56
    v_add_f32 v8, v8, v40
    v_add_f32 v10, v10, v26
    v_add_f32 v42, v42, v58
    v_add_f32 v10, v10, v42
    v_cvt_pk_bf16_f32 v76, v8, v10
    ds_write_b32 v5, v76 offset:0
    v_add_f32 v12, v12, v28
    v_add_f32 v44, v44, v60
    v_add_f32 v12, v12, v44
    v_add_f32 v14, v14, v30
    v_add_f32 v46, v46, v62
    v_add_f32 v14, v14, v46
    v_cvt_pk_bf16_f32 v77, v12, v14
    ds_write_b32 v5, v77 offset:320
    v_add_f32 v16, v16, v32
    v_add_f32 v48, v48, v64
    v_add_f32 v16, v16, v48
    v_add_f32 v18, v18, v34
    v_add_f32 v50, v50, v66
    v_add_f32 v18, v18, v50
    v_cvt_pk_bf16_f32 v78, v16, v18
    ds_write_b32 v5, v78 offset:640
    v_add_f32 v20, v20, v36
    v_add_f32 v52, v52, v68
    v_add_f32 v20, v20, v52
    v_add_f32 v22, v22, v38
    v_add_f32 v54, v54, v70
    v_add_f32 v22, v22, v54
    v_cvt_pk_bf16_f32 v79, v20, v22
    ds_write_b32 v5, v79 offset:960
    v_cmp_ne_u32 vcc, s54, v72
    v_mov_b32 v7, 2
    s_cbranch_vccz L_qfast
    v_mov_b32 v7, 1
    s_cmp_gt_u32 s47, 4
    s_cbranch_scc1 L_qfast
    s_add_u32 s34, s48, 1048576
    s_add_u32 s35, s48, 1064960
    s_add_u32 s36, s49, 1048576
    buffer_store_dwordx2 v[80:81], v90, s[40:43], s34 offen sc1
    buffer_store_dwordx2 v[82:83], v90, s[40:43], s35 offen sc1
    s_mov_b64 exec, 1
    buffer_store_dwordx2 v[84:85], v90, s[40:43], s36 offen sc1
    s_mov_b64 exec, -1
L_qfast:
    ds_write_b32 v6, v7
    v_lshrrev_b32 v25, 1, v0
    v_lshlrev_b32 v25, 8, v25
    v_and_b32 v20, 1, v0
    v_lshl_add_u32 v25, v20, 5, v25
    s_lshl_b32 s30, s21, 13
    s_lshl_b32 s27, s25, 6
    s_add_u32 s30, s30, s27
    s_add_u32 s30, s30, 65536
    v_bfe_u32 v4, v0, 1, 3
    v_lshlrev_b32 v4, 4, v4
    v_lshl_add_u32 v4, v2, 2, v4
    v_add_u32 v4, 152320, v4
    s_mov_b32 s47, 0x1000000
L_qpw:
    ds_read_b128 v[8:11], v6 offset:16
    s_sub_u32 s47, s47, 1
    s_cbranch_scc1 L_qpw_done
    s_waitcnt lgkmcnt(0)
    v_bitop3_b32 v12, v8, v9, v10 bitop3:0x80
    v_and_b32 v12, v12, v11
    v_cmp_eq_u32 vcc, 0, v12
    s_sleep 1
    s_cbranch_vccnz L_qpw
L_qpw_done:
    s_branch L_mlpoll
L_mlagain:
L_mlt:
    ds_read_b32 v12, v6 offset:4
    s_sub_u32 s47, s47, 1
    s_cbranch_scc1 L_mlt_done
    s_waitcnt lgkmcnt(0)
    v_cmp_gt_i32 vcc, 131072, v12
    s_cbranch_vccz L_mlt_done
    s_sleep 1
    s_branch L_mlt
L_mlt_done:
L_mlpoll:
    buffer_load_dwordx4 v[96:99], v25, s[40:43], s30 offen sc1
    buffer_load_dwordx4 v[100:103], v25, s[40:43], s30 offen offset:16 sc1
    s_sub_u32 s47, s47, 16
    s_cbranch_scc1 L_ml_done
    s_waitcnt vmcnt(0)
    v_xor_b32 v96, s52, v96
    v_xor_b32 v98, s52, v98
    v_bitop3_b32 v105, v97, v99, s50 bitop3:0x7e
    v_or_b32 v104, v96, v98
    v_xor_b32 v100, s52, v100
    v_xor_b32 v102, s52, v102
    v_bitop3_b32 v105, v105, v101, s50 bitop3:0xf6
    v_or3_b32 v104, v104, v100, v102
    v_bitop3_b32 v105, v105, v103, s50 bitop3:0xf6
    v_and_or_b32 v104, v104, s53, v105
    v_cmp_ne_u32 vcc, 0, v104
    s_cbranch_vccnz L_mlagain
L_ml_done:
    v_lshrrev_b32 v100, 8, v100
    v_add_f32 v98, v98, v102
    v_bfi_b32 v96, s53, v100, v96
    s_nop 1
    v_max_f32_dpp v104, v96, v96 quad_perm:[2,3,0,1] row_mask:0xf bank_mask:0xf
    s_nop 1
    v_max_f32_dpp v104, v104, v104 row_ror:4 row_mask:0xf bank_mask:0xf
    s_nop 1
    v_max_f32_dpp v104, v104, v104 row_ror:8 row_mask:0xf bank_mask:0xf
    v_mov_b32 v105, v104
    s_nop 1
    v_permlane16_swap_b32 v105, v104
    v_max_f32 v104, v104, v105
    v_sub_f32 v96, v96, v104
    v_exp_f32 v96, v96
    s_nop 0
    v_mul_f32 v104, v96, v98
    s_nop 1
    v_add_f32_dpp v104, v104, v104 quad_perm:[1,0,3,2] row_mask:0xf bank_mask:0xf
    s_nop 1
    v_add_f32_dpp v104, v104, v104 quad_perm:[2,3,0,1] row_mask:0xf bank_mask:0xf
    s_nop 1
    v_add_f32_dpp v104, v104, v104 row_ror:4 row_mask:0xf bank_mask:0xf
    s_nop 1
    v_add_f32_dpp v104, v104, v104 row_ror:8 row_mask:0xf bank_mask:0xf
    v_mov_b32 v105, v104
    s_nop 1
    v_permlane16_swap_b32 v105, v104
    v_add_f32 v104, v104, v105
    v_rcp_f32 v104, v104
    s_nop 0
    v_mul_f32 v104, v96, v104
    ds_write_b32 v4, v104
    ds_write_b32 v6, v7 offset:8
    s_waitcnt lgkmcnt(0)
    s_endpgm
L_compute:
    s_sub_u32 s25, s20, 2
    v_mov_b32 v15, 151616
    s_lshl_b32 s44, s21, 5
    s_add_u32 s44, s44, s22
    s_waitcnt lgkmcnt(0)
    s_load_dwordx2 s[50:51], s[18:19], 0
    s_mov_b32 s40, s18
    s_mov_b32 s41, s19
    s_mov_b32 s42, 3276800
    s_mov_b32 s43, 0x20000
    s_lshl_b32 s32, s44, 8
    s_lshl_b32 s27, s25, 4
    s_add_u32 s32, s32, s27
    s_add_u32 s32, s32, 65536
    v_lshlrev_b32 v22, 6, v0
    s_cmp_lg_u32 s25, 0
    s_cbranch_scc1 L_nomlp
    s_mov_b64 exec, 5
    buffer_load_dword v32, v22, s[40:43], s32 offen sc1
    s_mov_b64 exec, -1
L_nomlp:
    s_mul_i32 s28, s44, 2176
    s_lshl_b32 s27, s25, 7
    s_add_u32 s28, s28, s27
    s_add_u32 s28, s28, 1572864
    s_lshl_b32 s27, s25, 8
    v_lshlrev_b32 v23, 9, v2
    v_lshl_add_u32 v23, v1, 3, v23
    s_and_b32 s31, s22, 3
    s_lshl_b32 s31, s31, 6
    s_lshr_b32 s3, s44, 2
    s_add_u32 s31, s31, s3
    s_mul_i32 s31, s31, 2176
    s_add_u32 s31, s31, s27
    s_add_u32 s31, s31, 2686976
    v_and_b32 v29, 31, v0
    v_lshlrev_b32 v29, 3, v29
    v_lshrrev_b32 v3, 5, v0
    v_lshl_add_u32 v29, v3, 10, v29
    s_lshl_b32 s30, s22, 7
    s_lshl_b32 s3, s21, 3
    s_add_u32 s30, s30, s3
    s_add_u32 s30, s30, 32768
    v_xor_b32 v3, v1, v2
    v_lshlrev_b32 v3, 4, v3
    v_lshl_add_u32 v4, v1, 8, v3
    s_lshl_b32 s3, s25, 14
    v_add_u32 v4, s3, v4
    v_xor_b32 v5, 64, v4
    v_xor_b32 v6, 128, v4
    v_xor_b32 v7, 192, v4
    v_and_b32 v3, 3, v0
    v_mul_u32_u24 v8, 320, v3
    v_lshl_add_u32 v8, v2, 4, v8
    v_add_u32 v8, 147456, v8
    v_lshlrev_b32 v10, 4, v3
    v_add_u32 v10, 151552, v10
    s_lshl_b32 s3, s25, 2
    v_add_u32 v9, s3, v10
    v_add_u32 v30, s3, v15
    v_mul_u32_u24 v11, 576, v3
    v_lshrrev_b32 v12, 2, v1
    v_lshl_add_u32 v11, v12, 5, v11
    v_lshl_add_u32 v11, v2, 3, v11
    s_lshl_b32 s3, s25, 7
    s_add_u32 s3, s3, 148992
    v_add_u32 v11, s3, v11
    v_mul_u32_u24 v12, 576, v12
    v_lshl_add_u32 v12, v2, 4, v12
    v_add_u32 v12, 148992, v12
    v_lshrrev_b32 v13, 2, v1
    v_and_b32 v14, 1, v2
    v_lshl_or_b32 v14, v14, 2, v13
    v_lshlrev_b32 v14, 1, v14
    v_bfe_u32 v20, v0, 1, 1
    s_lshl_b32 s3, s25, 2
    v_or_b32 v20, s3, v20
    v_xor_b32 v14, v14, v20
    v_lshl_add_u32 v13, v2, 3, v13
    v_lshlrev_b32 v13, 8, v13
    v_lshl_add_u32 v13, v14, 4, v13
    v_and_b32 v14, 1, v0
    v_lshl_add_u32 v13, v14, 3, v13
    v_add_u32 v13, 65536, v13
    v_xor_b32 v14, 32, v13
    v_lshrrev_b32 v25, 2, v0
    v_mul_u32_u24 v24, 2176, v25
    v_lshl_add_u32 v24, v3, 4, v24
    s_mul_i32 s29, s21, 69632
    s_lshr_b32 s27, s22, 2
    s_lshl_b32 s27, s27, 8
    s_add_u32 s29, s29, s27
    s_lshl_b32 s27, s25, 6
    s_add_u32 s29, s29, s27
    s_add_u32 s29, s29, 1572864
    s_add_u32 s33, s29, 34816
    v_and_b32 v20, 7, v25
    v_lshlrev_b32 v20, 4, v20
    v_lshrrev_b32 v25, 5, v0
    v_lshl_add_u32 v25, v25, 2, v20
    v_add_u32 v25, 152320, v25
    v_bfe_u32 v26, v0, 3, 1
    v_mul_u32_u24 v26, 144, v26
    v_and_b32 v27, 1, v2
    v_lshl_add_u32 v26, v27, 5, v26
    v_lshl_add_u32 v26, v3, 2, v26
    v_lshrrev_b32 v27, 5, v0
    v_lshl_add_u32 v26, v27, 1, v26
    s_lshr_b32 s27, s25, 1
    s_lshl_b32 s27, s27, 6
    s_and_b32 s3, s25, 1
    s_lshl_b32 s3, s3, 4
    s_add_u32 s27, s27, s3
    s_add_u32 s27, s27, 151808
    v_add_u32 v26, s27, v26
    v_bfe_u32 v28, v0, 3, 1
    v_mul_u32_u24 v28, 144, v28
    v_lshl_add_u32 v28, v2, 4, v28
    v_add_u32 v28, 151808, v28
    v_add_u32 v16, 65536, v13
    v_add_u32 v17, 65536, v14
    v_mov_b32 v27, 1
    s_waitcnt lgkmcnt(0)
    s_add_u32 s50, s50, 0x9e3779b9
    s_addc_u32 s51, s51, 0x7f4a7c15
    s_and_b32 s52, s51, 0xff
    s_movk_i32 s53, 0xff
    v_mov_b32 v31, s52
    v_mov_b32 v18, s50
    v_mov_b32 v19, s51
    s_movk_i32 s36, 0x3ff
    s_and_b32 s88, s50, s36
    s_bfe_u32 s89, s50, 0xa000a
    s_bfe_u32 s90, s50, 0xa0014
    s_and_b32 s91, s51, s36
    v_and_b32 v20, 1, v0
    v_cmp_eq_u32 vcc, 1, v20
    v_mov_b32 v124, s88
    v_mov_b32 v125, s89
    v_mov_b32 v126, s90
    v_mov_b32 v127, s91
    v_cndmask_b32 v2, v124, v126, vcc
    v_cndmask_b32 v1, v125, v127, vcc
    s_mov_b32 s47, 0x1000000
    s_add_u32 s38, s25, 1
    s_lshl_b32 s38, s38, 14
L_kw:
    ds_read_b32 v20, v15 offset:4
    s_sub_u32 s47, s47, 1
    s_cbranch_scc1 L_kw_done
    s_waitcnt lgkmcnt(0)
    v_cmp_gt_i32 vcc, s38, v20
    s_cbranch_vccz L_kw_done
    s_sleep 1
    s_branch L_kw
L_kw_done:
    s_waitcnt vmcnt(0)
    ds_read_b128 v[32:35], v4 offset:0
    ds_read_b128 v[36:39], v5 offset:0
    ds_read_b128 v[40:43], v6 offset:0
    ds_read_b128 v[44:47], v7 offset:0
    ds_read_b128 v[48:51], v4 offset:4096
    ds_read_b128 v[52:55], v5 offset:4096
    ds_read_b128 v[56:59], v6 offset:4096
    ds_read_b128 v[60:63], v7 offset:4096
    s_waitcnt lgkmcnt(4)
    ds_read_b128 v[64:67], v4 offset:8192
    ds_read_b128 v[68:71], v5 offset:8192
    ds_read_b128 v[72:75], v6 offset:8192
    ds_read_b128 v[76:79], v7 offset:8192
    ds_read_b128 v[80:83], v4 offset:12288
    ds_read_b128 v[84:87], v5 offset:12288
    ds_read_b128 v[88:91], v6 offset:12288
    ds_read_b128 v[92:95], v7 offset:12288
L_qw:
    ds_read_b32 v20, v15 offset:0
    s_sub_u32 s47, s47, 1
    s_cbranch_scc1 L_qw_done
    s_waitcnt lgkmcnt(0)
    v_cmp_gt_i32 vcc, 1, v20
    s_cbranch_vccz L_qw_done
    s_sleep 1
    s_branch L_qw
L_qw_done:
    ds_read_b128 v[96:99], v8 offset:0
    ds_read_b128 v[100:103], v8 offset:64
    ds_read_b128 v[104:107], v8 offset:128
    ds_read_b128 v[108:111], v8 offset:192
    v_readfirstlane_b32 s34, v20
    s_waitcnt lgkmcnt(0)
    v_mfma_f32_16x16x32_bf16 v[112:115], v[32:35], v[96:99], 0
    v_mfma_f32_16x16x32_bf16 v[116:119], v[48:51], v[96:99], 0
    v_mfma_f32_16x16x32_bf16 v[120:123], v[64:67], v[96:99], 0
    v_mfma_f32_16x16x32_bf16 v[124:127], v[80:83], v[96:99], 0
    v_mfma_f32_16x16x32_bf16 v[112:115], v[36:39], v[100:103], v[112:115]
    v_mfma_f32_16x16x32_bf16 v[116:119], v[52:55], v[100:103], v[116:119]
    v_mfma_f32_16x16x32_bf16 v[120:123], v[68:71], v[100:103], v[120:123]
    v_mfma_f32_16x16x32_bf16 v[124:127], v[84:87], v[100:103], v[124:127]
    v_mfma_f32_16x16x32_bf16 v[112:115], v[40:43], v[104:107], v[112:115]
    v_mfma_f32_16x16x32_bf16 v[116:119], v[56:59], v[104:107], v[116:119]
    v_mfma_f32_16x16x32_bf16 v[120:123], v[72:75], v[104:107], v[120:123]
    v_mfma_f32_16x16x32_bf16 v[124:127], v[88:91], v[104:107], v[124:127]
    v_mfma_f32_16x16x32_bf16 v[112:115], v[44:47], v[108:111], v[112:115]
    v_mfma_f32_16x16x32_bf16 v[116:119], v[60:63], v[108:111], v[116:119]
    v_mfma_f32_16x16x32_bf16 v[120:123], v[76:79], v[108:111], v[120:123]
    v_mfma_f32_16x16x32_bf16 v[124:127], v[92:95], v[108:111], v[124:127]
    s_nop 7
    v_mov_b32_dpp v112, v116 quad_perm:[0,1,2,3] row_mask:0xf bank_mask:0x2
    v_mov_b32_dpp v113, v117 quad_perm:[0,1,2,3] row_mask:0xf bank_mask:0x2
    v_mov_b32_dpp v114, v118 quad_perm:[0,1,2,3] row_mask:0xf bank_mask:0x2
    v_mov_b32_dpp v115, v119 quad_perm:[0,1,2,3] row_mask:0xf bank_mask:0x2
    v_mov_b32_dpp v112, v120 quad_perm:[0,1,2,3] row_mask:0xf bank_mask:0x4
    v_mov_b32_dpp v113, v121 quad_perm:[0,1,2,3] row_mask:0xf bank_mask:0x4
    v_mov_b32_dpp v114, v122 quad_perm:[0,1,2,3] row_mask:0xf bank_mask:0x4
    v_mov_b32_dpp v115, v123 quad_perm:[0,1,2,3] row_mask:0xf bank_mask:0x4
    v_mov_b32_dpp v112, v124 quad_perm:[0,1,2,3] row_mask:0xf bank_mask:0x8
    v_mov_b32_dpp v113, v125 quad_perm:[0,1,2,3] row_mask:0xf bank_mask:0x8
    v_mov_b32_dpp v114, v126 quad_perm:[0,1,2,3] row_mask:0xf bank_mask:0x8
    v_mov_b32_dpp v115, v127 quad_perm:[0,1,2,3] row_mask:0xf bank_mask:0x8
    s_mov_b32 s26, 0x3db504f3
    s_mov_b32 s27, 0xffff0000
    v_cvt_pk_bf16_f32 v96, v112, v113
    v_cvt_pk_bf16_f32 v97, v114, v115
    v_lshlrev_b32 v112, 16, v96
    v_and_b32 v113, s27, v96
    v_lshlrev_b32 v114, 16, v97
    v_and_b32 v115, s27, v97
    v_mul_f32 v112, s26, v112
    v_mul_f32 v113, s26, v113
    v_mul_f32 v114, s26, v114
    v_mul_f32 v115, s26, v115
    v_cvt_pk_bf16_f32 v96, v112, v113
    v_cvt_pk_bf16_f32 v97, v114, v115
    v_lshlrev_b32 v112, 16, v96
    v_and_b32 v113, s27, v96
    v_lshlrev_b32 v114, 16, v97
    v_and_b32 v115, s27, v97
    v_max3_f32 v20, v112, v113, v114
    v_max_f32 v20, v20, v115
    s_nop 1
    v_max_f32_dpp v20, v20, v20 row_ror:4 row_mask:0xf bank_mask:0xf
    s_nop 1
    v_max_f32_dpp v20, v20, v20 row_ror:8 row_mask:0xf bank_mask:0xf
    v_mov_b32 v21, v20
    s_nop 1
    v_permlane16_swap_b32 v21, v20
    s_nop 1
    v_max_f32 v20, v20, v21
    v_mov_b32 v21, v20
    s_nop 1
    v_permlane32_swap_b32 v21, v20
    s_nop 1
    v_max_f32 v20, v20, v21
    v_min_u32 v20, -2, v20
    ds_write_b32 v9, v20
L_mw:
    ds_read_b128 v[96:99], v10
    s_sub_u32 s47, s47, 1
    s_cbranch_scc1 L_mw_done
    s_waitcnt lgkmcnt(0)
    v_max3_u32 v20, v96, v97, v98
    v_max_u32 v20, v20, v99
    v_cmp_eq_u32 vcc, -1, v20
    s_cbranch_vccnz L_mw
L_mw_done:
    s_waitcnt lgkmcnt(0)
    s_mov_b32 s26, 0x3fb8aa3b
    v_max3_f32 v20, v96, v97, v98
    v_max_f32 v20, v20, v99
    v_mul_f32 v20, s26, v20
    v_fma_f32 v112, v112, s26, -v20
    v_fma_f32 v113, v113, s26, -v20
    v_fma_f32 v114, v114, s26, -v20
    v_fma_f32 v115, v115, s26, -v20
    v_exp_f32 v112, v112
    v_exp_f32 v113, v113
    v_exp_f32 v114, v114
    v_exp_f32 v115, v115
    s_and_b32 s27, s25, 1
    v_cvt_pk_bf16_f32 v96, v112, v113
    v_cvt_pk_bf16_f32 v97, v114, v115
    ds_write_b64 v11, v[96:97]
    v_add_f32 v21, v112, v113
    v_add_f32 v98, v114, v115
    v_add_f32 v21, v21, v98
    s_nop 1
    v_add_f32_dpp v21, v21, v21 row_ror:4 row_mask:0xf bank_mask:0xf
    s_nop 1
    v_add_f32_dpp v21, v21, v21 row_ror:8 row_mask:0xf bank_mask:0xf
    v_mov_b32 v98, v21
    s_nop 1
    v_permlane16_swap_b32 v98, v21
    s_nop 1
    v_add_f32 v21, v21, v98
    v_mov_b32 v98, v21
    s_nop 1
    v_permlane32_swap_b32 v98, v21
    s_nop 1
    v_add_f32 v21, v21, v98
    s_lshl_b32 s27, s27, 3
    v_lshlrev_b32 v20, s27, v20
    v_bfi_b32 v100, s53, v31, v20
    v_mov_b32 v101, s50
    v_bfi_b32 v102, s53, v31, v21
    v_mov_b32 v103, s50
    s_mov_b64 exec, 0xf
    s_cmp_eq_u32 s34, 2
    s_cbranch_scc0 L_mlslow
    buffer_store_dwordx4 v[100:103], v22, s[40:43], s32 offen
    s_branch L_mlpub
L_mlslow:
    buffer_store_dwordx4 v[100:103], v22, s[40:43], s32 offen sc1
L_mlpub:
    s_mov_b64 exec, -1
    ds_write_b32 v30, v27 offset:16
    v_mov_b32 v121, s50
    v_mov_b32 v123, s50
L_pw:
    ds_read_b128 v[96:99], v15 offset:16
    s_sub_u32 s47, s47, 1
    s_cbranch_scc1 L_pw_done
    s_waitcnt lgkmcnt(0)
    v_bitop3_b32 v20, v96, v97, v98 bitop3:0x80
    v_and_b32 v20, v20, v99
    v_cmp_eq_u32 vcc, 0, v20
    s_cbranch_vccnz L_pw
L_pw_done:
    ds_read_b128 v[32:35], v12 offset:0
    ds_read_b128 v[36:39], v12 offset:64
    ds_read_b128 v[40:43], v12 offset:128
    ds_read_b128 v[44:47], v12 offset:192
    ds_read_b128 v[48:51], v12 offset:256
    ds_read_b128 v[52:55], v12 offset:320
    ds_read_b128 v[56:59], v12 offset:384
    ds_read_b128 v[60:63], v12 offset:448
    ds_read_b32 v20, v15 offset:4
    s_waitcnt lgkmcnt(0)
    v_cmp_gt_i32 vcc, 73728, v20
    s_cbranch_vccz L_vw0_done
L_vw0:
    ds_read_b32 v20, v15 offset:4
    s_sub_u32 s47, s47, 1
    s_cbranch_scc1 L_vw0_done
    s_waitcnt lgkmcnt(0)
    v_cmp_gt_i32 vcc, 73728, v20
    s_cbranch_vccz L_vw0_done
    s_sleep 1
    s_branch L_vw0
L_vw0_done:
    ds_read_b64_tr_b16 v[96:97], v13 offset:0
    ds_read_b64_tr_b16 v[98:99], v13 offset:1024
    ds_read_b64_tr_b16 v[100:101], v14 offset:0
    ds_read_b64_tr_b16 v[102:103], v14 offset:1024
    ds_read_b32 v20, v15 offset:4
    s_waitcnt lgkmcnt(0)
    v_mfma_f32_16x16x32_bf16 v[112:115], v[32:35], v[96:99], 0
    v_mfma_f32_16x16x32_bf16 v[116:119], v[32:35], v[100:103], 0
    v_cmp_gt_i32 vcc, 81920, v20
    s_cbranch_vccz L_vw1_done
L_vw1:
    ds_read_b32 v20, v15 offset:4
    s_sub_u32 s47, s47, 1
    s_cbranch_scc1 L_vw1_done
    s_waitcnt lgkmcnt(0)
    v_cmp_gt_i32 vcc, 81920, v20
    s_cbranch_vccz L_vw1_done
    s_sleep 1
    s_branch L_vw1
L_vw1_done:
    ds_read_b64_tr_b16 v[104:105], v13 offset:8192
    ds_read_b64_tr_b16 v[106:107], v13 offset:9216
    ds_read_b64_tr_b16 v[108:109], v14 offset:8192
    ds_read_b64_tr_b16 v[110:111], v14 offset:9216
    ds_read_b32 v20, v15 offset:4
    s_waitcnt lgkmcnt(0)
    v_mfma_f32_16x16x32_bf16 v[112:115], v[36:39], v[104:107], v[112:115]
    v_mfma_f32_16x16x32_bf16 v[116:119], v[36:39], v[108:111], v[116:119]
    v_cmp_gt_i32 vcc, 90112, v20
    s_cbranch_vccz L_vw2_done
L_vw2:
    ds_read_b32 v20, v15 offset:4
    s_sub_u32 s47, s47, 1
    s_cbranch_scc1 L_vw2_done
    s_waitcnt lgkmcnt(0)
    v_cmp_gt_i32 vcc, 90112, v20
    s_cbranch_vccz L_vw2_done
    s_sleep 1
    s_branch L_vw2
L_vw2_done:
    ds_read_b64_tr_b16 v[96:97], v13 offset:16384
    ds_read_b64_tr_b16 v[98:99], v13 offset:17408
    ds_read_b64_tr_b16 v[100:101], v14 offset:16384
    ds_read_b64_tr_b16 v[102:103], v14 offset:17408
    ds_read_b32 v20, v15 offset:4
    s_waitcnt lgkmcnt(0)
    v_mfma_f32_16x16x32_bf16 v[112:115], v[40:43], v[96:99], v[112:115]
    v_mfma_f32_16x16x32_bf16 v[116:119], v[40:43], v[100:103], v[116:119]
    v_cmp_gt_i32 vcc, 98304, v20
    s_cbranch_vccz L_vw3_done
L_vw3:
    ds_read_b32 v20, v15 offset:4
    s_sub_u32 s47, s47, 1
    s_cbranch_scc1 L_vw3_done
    s_waitcnt lgkmcnt(0)
    v_cmp_gt_i32 vcc, 98304, v20
    s_cbranch_vccz L_vw3_done
    s_sleep 1
    s_branch L_vw3
L_vw3_done:
    ds_read_b64_tr_b16 v[104:105], v13 offset:24576
    ds_read_b64_tr_b16 v[106:107], v13 offset:25600
    ds_read_b64_tr_b16 v[108:109], v14 offset:24576
    ds_read_b64_tr_b16 v[110:111], v14 offset:25600
    ds_read_b32 v20, v15 offset:4
    s_waitcnt lgkmcnt(0)
    v_mfma_f32_16x16x32_bf16 v[112:115], v[44:47], v[104:107], v[112:115]
    v_mfma_f32_16x16x32_bf16 v[116:119], v[44:47], v[108:111], v[116:119]
    v_cmp_gt_i32 vcc, 106496, v20
    s_cbranch_vccz L_vw4_done
L_vw4:
    ds_read_b32 v20, v15 offset:4
    s_sub_u32 s47, s47, 1
    s_cbranch_scc1 L_vw4_done
    s_waitcnt lgkmcnt(0)
    v_cmp_gt_i32 vcc, 106496, v20
    s_cbranch_vccz L_vw4_done
    s_sleep 1
    s_branch L_vw4
L_vw4_done:
    ds_read_b64_tr_b16 v[96:97], v13 offset:32768
    ds_read_b64_tr_b16 v[98:99], v13 offset:33792
    ds_read_b64_tr_b16 v[100:101], v14 offset:32768
    ds_read_b64_tr_b16 v[102:103], v14 offset:33792
    ds_read_b32 v20, v15 offset:4
    s_waitcnt lgkmcnt(0)
    v_mfma_f32_16x16x32_bf16 v[112:115], v[48:51], v[96:99], v[112:115]
    v_mfma_f32_16x16x32_bf16 v[116:119], v[48:51], v[100:103], v[116:119]
    v_cmp_gt_i32 vcc, 114688, v20
    s_cbranch_vccz L_vw5_done
L_vw5:
    ds_read_b32 v20, v15 offset:4
    s_sub_u32 s47, s47, 1
    s_cbranch_scc1 L_vw5_done
    s_waitcnt lgkmcnt(0)
    v_cmp_gt_i32 vcc, 114688, v20
    s_cbranch_vccz L_vw5_done
    s_sleep 1
    s_branch L_vw5
L_vw5_done:
    ds_read_b64_tr_b16 v[104:105], v13 offset:40960
    ds_read_b64_tr_b16 v[106:107], v13 offset:41984
    ds_read_b64_tr_b16 v[108:109], v14 offset:40960
    ds_read_b64_tr_b16 v[110:111], v14 offset:41984
    ds_read_b32 v20, v15 offset:4
    s_waitcnt lgkmcnt(0)
    v_mfma_f32_16x16x32_bf16 v[112:115], v[52:55], v[104:107], v[112:115]
    v_mfma_f32_16x16x32_bf16 v[116:119], v[52:55], v[108:111], v[116:119]
    v_cmp_gt_i32 vcc, 122880, v20
    s_cbranch_vccz L_vw6_done
L_vw6:
    ds_read_b32 v20, v15 offset:4
    s_sub_u32 s47, s47, 1
    s_cbranch_scc1 L_vw6_done
    s_waitcnt lgkmcnt(0)
    v_cmp_gt_i32 vcc, 122880, v20
    s_cbranch_vccz L_vw6_done
    s_branch L_vw6
L_vw6_done:
    ds_read_b64_tr_b16 v[96:97], v13 offset:49152
    ds_read_b64_tr_b16 v[98:99], v13 offset:50176
    ds_read_b64_tr_b16 v[100:101], v14 offset:49152
    ds_read_b64_tr_b16 v[102:103], v14 offset:50176
    ds_read_b32 v20, v15 offset:4
    s_waitcnt lgkmcnt(0)
    v_mfma_f32_16x16x32_bf16 v[112:115], v[56:59], v[96:99], v[112:115]
    v_mfma_f32_16x16x32_bf16 v[116:119], v[56:59], v[100:103], v[116:119]
    v_cmp_gt_i32 vcc, 131072, v20
    s_cbranch_vccz L_vw7_done
L_vw7:
    ds_read_b32 v20, v15 offset:4
    s_sub_u32 s47, s47, 1
    s_cbranch_scc1 L_vw7_done
    s_waitcnt lgkmcnt(0)
    v_cmp_gt_i32 vcc, 131072, v20
    s_cbranch_vccz L_vw7_done
    s_branch L_vw7
L_vw7_done:
    ds_read_b64_tr_b16 v[104:105], v13 offset:57344
    ds_read_b64_tr_b16 v[106:107], v13 offset:58368
    ds_read_b64_tr_b16 v[108:109], v14 offset:57344
    ds_read_b64_tr_b16 v[110:111], v14 offset:58368
    s_waitcnt lgkmcnt(2)
    v_mfma_f32_16x16x32_bf16 v[112:115], v[60:63], v[104:107], v[112:115]
    s_waitcnt lgkmcnt(0)
    v_mfma_f32_16x16x32_bf16 v[116:119], v[60:63], v[108:111], v[116:119]
    s_cmp_eq_u32 s34, 2
    s_mov_b32 s47, 0x200000
    s_nop 4
    v_bfi_b32 v122, s36, v2, v112
    v_bfi_b32 v123, s36, v1, v116
    s_cbranch_scc0 L_oslow
    buffer_store_dwordx2 v[122:123], v23, s[40:43], s28 offen
    s_branch L_opub
L_oslow:
    buffer_store_dwordx2 v[122:123], v23, s[40:43], s28 offen sc1
L_opub:
    s_mov_b32 s46, 0x1000000
    buffer_load_dwordx4 v[64:67], v24, s[40:43], s29 offen sc1
    buffer_load_dwordx4 v[68:71], v24, s[40:43], s33 offen sc1
    s_waitcnt vmcnt(1)
L_wow:
    ds_read_b32 v21, v15 offset:4
    s_sub_u32 s46, s46, 1
    s_cbranch_scc1 L_wow_done
    s_waitcnt lgkmcnt(0)
    v_cmp_gt_i32 vcc, 147456, v21
    s_cbranch_vccz L_wow_done
    s_branch L_wow
L_wow_done:
    ds_read_b64_tr_b16 v[80:81], v16 offset:0
    ds_read_b64_tr_b16 v[82:83], v16 offset:1024
    ds_read_b64_tr_b16 v[84:85], v16 offset:8192
    ds_read_b64_tr_b16 v[86:87], v16 offset:9216
    ds_read_b64_tr_b16 v[88:89], v17 offset:0
    ds_read_b64_tr_b16 v[90:91], v17 offset:1024
    ds_read_b64_tr_b16 v[92:93], v17 offset:8192
    ds_read_b64_tr_b16 v[94:95], v17 offset:9216
    ds_read_b32 v20, v15 offset:8
    ds_read2_b32 v[96:97], v25 offset0:0 offset1:2
    buffer_load_dwordx4 v[48:51], v24, s[40:43], s29 offen sc1
    buffer_load_dwordx4 v[52:55], v24, s[40:43], s33 offen sc1
    s_waitcnt vmcnt(3)
    v_xor_b32 v32, s88, v64
    v_xor_b32 v33, s89, v65
    v_xor_b32 v34, s90, v66
    v_xor_b32 v35, s91, v67
    v_or3_b32 v40, v32, v33, v34
    s_waitcnt vmcnt(2)
    v_xor_b32 v36, s88, v68
    v_xor_b32 v37, s89, v69
    v_xor_b32 v38, s90, v70
    v_xor_b32 v39, s91, v71
    v_or3_b32 v40, v40, v35, v36
    v_or3_b32 v41, v37, v38, v39
    v_bitop3_b32 v40, v40, v41, s36 bitop3:0xa8
    v_cmp_ne_u32 vcc, 0, v40
    s_mov_b64 exec, vcc
    s_cbranch_vccz L_ox_done
L_oxpoll:
    buffer_load_dwordx4 v[64:67], v24, s[40:43], s29 offen sc1
    buffer_load_dwordx4 v[68:71], v24, s[40:43], s33 offen sc1
    s_mov_b64 exec, -1
    ds_read_b32 v20, v15 offset:8
    ds_read2_b32 v[96:97], v25 offset0:0 offset1:2
    s_mov_b64 exec, vcc
    s_waitcnt vmcnt(3)
    v_xor_b32 v32, s88, v48
    v_xor_b32 v33, s89, v49
    v_xor_b32 v34, s90, v50
    v_xor_b32 v35, s91, v51
    v_or3_b32 v40, v32, v33, v34
    s_waitcnt vmcnt(2)
    v_xor_b32 v36, s88, v52
    v_xor_b32 v37, s89, v53
    v_xor_b32 v38, s90, v54
    v_xor_b32 v39, s91, v55
    v_or3_b32 v40, v40, v35, v36
    v_or3_b32 v41, v37, v38, v39
    v_bitop3_b32 v40, v40, v41, s36 bitop3:0xa8
    v_cmp_ne_u32 vcc, 0, v40
    s_mov_b64 exec, vcc
    s_cbranch_vccz L_ox_done
    buffer_load_dwordx4 v[48:51], v24, s[40:43], s29 offen sc1
    buffer_load_dwordx4 v[52:55], v24, s[40:43], s33 offen sc1
    s_mov_b64 exec, -1
    ds_read_b32 v20, v15 offset:8
    ds_read2_b32 v[96:97], v25 offset0:0 offset1:2
    s_mov_b64 exec, vcc
    s_waitcnt vmcnt(3)
    v_xor_b32 v32, s88, v64
    v_xor_b32 v33, s89, v65
    v_xor_b32 v34, s90, v66
    v_xor_b32 v35, s91, v67
    v_or3_b32 v40, v32, v33, v34
    s_waitcnt vmcnt(2)
    v_xor_b32 v36, s88, v68
    v_xor_b32 v37, s89, v69
    v_xor_b32 v38, s90, v70
    v_xor_b32 v39, s91, v71
    v_or3_b32 v40, v40, v35, v36
    v_or3_b32 v41, v37, v38, v39
    v_bitop3_b32 v40, v40, v41, s36 bitop3:0xa8
    v_cmp_ne_u32 vcc, 0, v40
    s_mov_b64 exec, vcc
    s_cbranch_vccz L_ox_done
    s_sub_u32 s47, s47, 1
    s_cbranch_scc0 L_oxpoll
L_ox_done:
    s_mov_b64 exec, -1
    s_cmp_gt_u32 s25, 0
    s_cbranch_scc1 L_nogf
    s_mov_b64 exec, 1
    buffer_store_dwordx2 v[18:19], v22, s[40:43], s30 offen sc1
    s_mov_b64 exec, -1
L_nogf:
    s_waitcnt lgkmcnt(0)
    v_cmp_eq_u32 vcc, 0, v20
    s_cbranch_vccz L_wok
L_ww:
    ds_read_b32 v20, v15 offset:8
    s_sub_u32 s46, s46, 1
    s_cbranch_scc1 L_ww_done
    s_waitcnt lgkmcnt(0)
    v_cmp_gt_i32 vcc, 1, v20
    s_cbranch_vccz L_ww_done
    s_branch L_ww
L_ww_done:
    ds_read2_b32 v[96:97], v25 offset0:0 offset1:2
    s_waitcnt lgkmcnt(0)
L_wok:
    v_pk_mul_f32 v[32:33], v[32:33], v[96:97] op_sel_hi:[1,0]
    v_pk_mul_f32 v[34:35], v[34:35], v[96:97] op_sel_hi:[1,0]
    v_pk_mul_f32 v[36:37], v[36:37], v[96:97] op_sel:[0,1] op_sel_hi:[1,1]
    v_pk_mul_f32 v[38:39], v[38:39], v[96:97] op_sel:[0,1] op_sel_hi:[1,1]
    v_permlane32_swap_b32 v32, v34
    v_permlane32_swap_b32 v33, v35
    v_permlane32_swap_b32 v36, v38
    v_permlane32_swap_b32 v37, v39
    v_pk_add_f32 v[32:33], v[32:33], v[34:35]
    v_pk_add_f32 v[36:37], v[36:37], v[38:39]
    s_nop 0
    v_permlane16_swap_b32 v32, v33
    v_permlane16_swap_b32 v36, v37
    v_add_f32 v33, v32, v33
    v_add_f32 v36, v36, v37
    s_nop 0
    v_add_f32_dpp v32, v33, v33 row_ror:8 row_mask:0xf bank_mask:0x3
    v_add_f32_dpp v32, v36, v36 row_ror:8 row_mask:0xf bank_mask:0xc
    s_nop 1
    v_add_f32_dpp v33, v32, v32 row_shl:4 row_mask:0xf bank_mask:0x5
    v_add_f32_dpp v33, v32, v32 row_shr:4 row_mask:0xf bank_mask:0xa
    v_cvt_pk_bf16_f32 v32, v33, v33
    ds_write_b16 v26, v32
    ds_write_b32 v30, v27 offset:32
    s_mov_b32 s47, 0x1000000
L_ow:
    ds_read_b128 v[108:111], v15 offset:32
    ds_read_b128 v[100:103], v28
    ds_read_b128 v[104:107], v28 offset:64
    s_sub_u32 s47, s47, 1
    s_cbranch_scc1 L_ow_done
    s_waitcnt lgkmcnt(2)
    v_bitop3_b32 v20, v108, v109, v110 bitop3:0x80
    v_and_b32 v20, v20, v111
    v_cmp_eq_u32 vcc, 0, v20
    s_cbranch_vccnz L_ow
L_ow_done:
    s_waitcnt lgkmcnt(1)
    v_mfma_f32_16x16x32_bf16 v[112:115], v[100:103], v[80:83], 0
    v_mfma_f32_16x16x32_bf16 v[116:119], v[100:103], v[88:91], 0
    s_waitcnt lgkmcnt(0)
    v_mfma_f32_16x16x32_bf16 v[112:115], v[104:107], v[84:87], v[112:115]
    v_mfma_f32_16x16x32_bf16 v[116:119], v[104:107], v[92:95], v[116:119]
    s_nop 7
    v_mov_b32_dpp v112, v116 quad_perm:[0,1,2,3] row_mask:0xa bank_mask:0xf
    v_bfi_b32 v120, s53, v31, v112
    buffer_store_dwordx2 v[120:121], v29, s[40:43], s31 offen sc1
L_end:
    s_endpgm

.section .rodata,"a"
.p2align 6
.amdhsa_kernel standalone__sliding_block_cached__decode_kernel
  .amdhsa_next_free_vgpr 128
  .amdhsa_next_free_sgpr 100
  .amdhsa_accum_offset 128
  .amdhsa_group_segment_fixed_size 0
  .amdhsa_kernarg_size 64
  .amdhsa_user_sgpr_count 2
  .amdhsa_user_sgpr_kernarg_segment_ptr 1
  .amdhsa_system_sgpr_workgroup_id_x 1
.end_amdhsa_kernel
```
